```python
import torch

def _softmax(x, axis=-1):
    return torch.softmax(x, dim=axis)
def _gelu(x):
    return torch.nn.functional.gelu(x, approximate="tanh")
def _silu(x):
    return torch.nn.functional.silu(x)
def _sigmoid(x):
    return torch.sigmoid(x)
def _layernorm(x, axis=-1, eps=1e-5):
    m = x.mean(dim=axis, keepdim=True)
    v = x.var(dim=axis, keepdim=True, unbiased=False)
    return (x - m) / torch.sqrt(v + eps)
def _scatter_add(tgt, idx, src, axis=0):
    return tgt.clone().index_add_(axis, idx, src)
def _segment_sum(src, seg, n):
    out = torch.zeros((n,) + src.shape[1:], dtype=src.dtype)
    return out.index_add_(0, seg, src)
def _pad(x, pw):
    flat = tuple(v for pair in reversed(pw) for v in pair)
    return torch.nn.functional.pad(x, flat)

kernel_name = 'parallel_sum__sliding_block_cached__dense_activation_mish__decode'

def setup_inputs():

    _w = (lambda a: (lambda t: t.to(torch.bfloat16) if t.is_floating_point() else t)(torch.as_tensor(a)))
    def _A_setup():
        B, Sq, D = 2, 1, 512
        Hq, Hkv, Sk, Dh = 32, 8, 8192, 128
        assert Hq % Hkv == 0, (Hq, Hkv)
        return {
            "x": _w((lambda *s: torch.randn(*s, dtype=torch.bfloat16) * 0.05)(B, Sq, D)),
            "k_cache": _w((lambda *s: torch.randn(*s, dtype=torch.bfloat16) * 1.6)(B, Hkv, Sk, Dh)),
            "v_cache": _w((lambda *s: torch.randn(*s, dtype=torch.bfloat16) * 0.4)(B, Hkv, Sk, Dh)),
            "wq": _w((lambda *s: torch.randn(*s, dtype=torch.bfloat16) * 1.6)(D, Hq * Dh) * (D ** -0.5)),
            "wo": _w((lambda *s: torch.randn(*s, dtype=torch.bfloat16) * 0.4)(Hq * Dh, D) * ((Hq * Dh) ** -0.5)),
        }
    _A_in = _A_setup()

    def _B_setup():
        B, S, D, F = 2, 1, 512, 1792
        return {
            "x": _w((lambda *s: torch.randn(*s, dtype=torch.bfloat16) * 0.05)(B, S, D)),
            "w1": _w((lambda *s: torch.randn(*s, dtype=torch.bfloat16) * 0.8)(D, F) * (D ** -0.5)),
            "b1": _w((lambda *s: torch.randn(*s, dtype=torch.bfloat16) * 0.2)(F)),
            "w2": _w((lambda *s: torch.randn(*s, dtype=torch.bfloat16) * 0.1)(F, D) * (F ** -0.5)),
        }
    _B_in = _B_setup()

    return {
        "A_x": _A_in["x"],
        "A_k_cache": _A_in["k_cache"],
        "A_v_cache": _A_in["v_cache"],
        "A_wq": _A_in["wq"],
        "A_wo": _A_in["wo"],
        "B_x": _B_in["x"],
        "B_w1": _B_in["w1"],
        "B_b1": _B_in["b1"],
        "B_w2": _B_in["w2"],
    }

def reference(A_x, A_k_cache, A_v_cache, A_wq, A_wo, B_x, B_w1, B_b1, B_w2):
    def _A_ref(x, k_cache, v_cache, wq, wo):
        B, Sq, D = x.shape
        Hq, Dh = 32, 128
        Hkv, Sk = k_cache.shape[1], k_cache.shape[2]
        W = min(4096, max(256, Sk // 4))
        rep = Hq // Hkv
        q = (lambda x, *d: x.permute(*d))((x @ wq).reshape(B, Sq, Hq, Dh), 0, 2, 1, 3)
        k = (lambda x, n, axis: torch.repeat_interleave(x, n, dim=axis))(k_cache[:, :, Sk - W:, :], rep, axis=1)
        v = (lambda x, n, axis: torch.repeat_interleave(x, n, dim=axis))(v_cache[:, :, Sk - W:, :], rep, axis=1)
        scores = torch.einsum("bhqd,bhkd->bhqk", q, k) * (Dh ** -0.5)
        p = _softmax(scores, axis=-1)
        o = torch.einsum("bhqk,bhkd->bhqd", p, v)
        return (lambda x, *d: x.permute(*d))(o, 0, 2, 1, 3).reshape(B, Sq, Hq * Dh) @ wo

    def _B_ref(x, w1, b1, w2):
        h = torch.einsum("bsd,df->bsf", x, w1) + b1
        sp = torch.log1p(torch.exp(-torch.abs(h))) + torch.where(h > 0, h, torch.zeros_like(h))
        act = h * torch.tanh(sp)
        return torch.einsum("bsf,fd->bsd", act, w2)

    x = A_x
    xn = _layernorm(x, axis=-1)
    return x + _A_ref(xn, A_k_cache, A_v_cache, A_wq, A_wo) + _B_ref(xn, B_w1, B_b1, B_w2)
```

```asm
; @launch grid=(256,1,1) block=(256,1,1) lds=122880
.amdgcn_target "amdgcn-amd-amdhsa--gfx950"
.text
.globl parallel_sum__sliding_block_cached__dense_activation_mish__decode_kernel
.p2align 12
.p2align 8
.type parallel_sum__sliding_block_cached__dense_activation_mish__decode_kernel,@function
parallel_sum__sliding_block_cached__dense_activation_mish__decode_kernel:
    s_load_dwordx2 s[4:5], s[0:1], 0
    s_load_dwordx2 s[16:17], s[0:1], 24
    s_load_dwordx2 s[24:25], s[0:1], 48
    s_load_dwordx2 s[8:9], s[0:1], 8
    s_load_dwordx2 s[40:41], s[0:1], 88
    s_load_dwordx2 s[12:13], s[0:1], 16
    s_cmp_ge_u32 s2, 256
    s_cbranch_scc1 L_end
    s_getpc_b64 s[44:45]
L_pc:
    s_lshr_b32 s3, s2, 1
    s_and_b32 s3, s3, 0x7c
    v_lshrrev_b32 v2, 6, v0
    v_add_u32 v2, s3, v2
    v_lshlrev_b32 v2, 6, v2
    v_min_u32 v2, L_codeend-L_pc-4, v2
    global_load_dword v3, v2, s[44:45]
    v_readfirstlane_b32 s46, v0
    v_and_b32 v0, 63, v0
    s_and_b32 s47, s2, 7
    s_lshr_b32 s48, s2, 3
    s_lshr_b32 s46, s46, 6
    s_lshr_b32 s49, s48, 3
    s_and_b32 s50, s48, 7
    v_lshrrev_b32 v4, 4, v0
    v_and_b32 v5, 15, v0
    s_mov_b32 s6, 2048
    s_mov_b32 s7, 0x20000
    s_mov_b32 s18, 4194304
    s_mov_b32 s19, 0x20000
    v_lshlrev_b32 v8, 4, v0
    v_bfe_u32 v9, v0, 3, 1
    v_lshlrev_b32 v6, 10, v9
    v_lshl_add_u32 v10, v4, 4, v6
    v_and_b32 v6, 1, v4
    v_lshlrev_b32 v6, 1, v6
    v_and_b32 v7, 7, v0
    v_xor_b32 v6, v6, v7
    v_lshlrev_b32 v6, 4, v6
    v_lshrrev_b32 v7, 3, v0
    v_lshl_add_u32 v11, v7, 13, v6
    v_xor_b32 v12, 64, v11
    s_and_b32 s53, s50, 1
    s_lshl_b32 s54, s53, 1
    s_xor_b32 s54, s54, s46
    s_lshl_b32 s54, s54, 5
    s_lshl_b32 s55, s49, 7
    s_add_u32 s54, s54, s55
    s_lshl_b32 s56, s54, 13
    s_lshl_b32 s61, s47, 10
    s_add_u32 s56, s56, s61
    s_xor_b32 s61, s50, 1
    s_lshl_b32 s61, s61, 7
    s_add_u32 s56, s56, s61
    s_lshl_b32 s55, s54, 1
    s_lshl_b32 s61, s46, 12
    s_add_u32 m0, s61, 8192
    s_waitcnt lgkmcnt(0)
    buffer_load_dwordx4 v[20:23], v8, s[4:7], 0 offen
    buffer_load_dwordx4 v[24:27], v8, s[4:7], 0 offen offset:1024
    buffer_load_dwordx4 v[28:31], v10, s[4:7], s55 offen
    buffer_load_dwordx4 v11, s[16:19], s56 offen nt lds
    s_add_u32 m0, m0, 1024
    s_add_u32 s56, s56, 65536
    buffer_load_dwordx4 v12, s[16:19], s56 offen nt lds
    s_add_u32 m0, m0, 1024
    s_add_u32 s56, s56, 65536
    buffer_load_dwordx4 v11, s[16:19], s56 offen nt lds
    s_add_u32 m0, m0, 1024
    s_add_u32 s56, s56, 65536
    buffer_load_dwordx4 v12, s[16:19], s56 offen nt lds
    s_load_dwordx2 s[32:33], s[0:1], 64
    s_load_dwordx2 s[20:21], s[0:1], 32
    s_load_dwordx2 s[28:29], s[0:1], 56
    s_load_dwordx2 s[36:37], s[0:1], 72
    s_mov_b32 s10, 33554432
    s_mov_b32 s11, 0x20000
    s_lshr_b32 s65, s48, 4
    s_and_b32 s66, s48, 15
    s_lshl_b32 s53, s65, 3
    s_add_u32 s53, s53, s47
    s_lshl_b32 s58, s53, 21
    s_mul_i32 s53, s66, 4096
    s_add_u32 s58, s58, s53
    s_add_u32 s58, s58, 1572864
    s_mul_i32 s59, s46, 131072
    s_add_u32 s59, s59, s58
    s_and_b32 s76, s46, 1
    s_mul_i32 s76, s76, 0
    s_lshr_b32 s53, s46, 1
    s_mul_i32 s53, s53, 3
    s_xor_b32 s53, s53, s76
    s_lshl_b32 s53, s53, 12
    s_xor_b32 s59, s59, s53
    s_lshl_b32 s53, s46, 13
    s_lshl_b32 s61, s46, 11
    v_xor_b32 v6, v5, v4
    v_lshlrev_b32 v6, 4, v6
    v_lshl_add_u32 v16, v4, 8, v6
    v_xor_b32 v17, 64, v16
    v_xor_b32 v18, 0x80, v16
    v_xor_b32 v19, 0xc0, v16
    v_lshl_add_u32 v6, v5, 8, v6
    s_add_u32 s53, s53, 90112
    v_add_u32 v68, s53, v6
    s_load_dword s44, s[40:41], 0
    s_mov_b32 s42, 0x10000000
    s_mov_b32 s43, 0x20000
    s_mov_b32 s62, 0xffff0000
    s_mov_b32 s82, 0xff00ff00
    s_mov_b32 s83, 0xff00ff00
    v_mov_b32 v82, 0xff
    v_mov_b32 v83, 0
    v_lshlrev_b32 v84, 1, v0
    s_lshl_b32 s53, s46, 7
    v_add_u32 v84, s53, v84
    s_lshl_b32 s53, s46, 10
    v_add_u32 v96, s53, v8
    s_and_b32 s63, s46, 1
    s_lshr_b32 s64, s46, 1
    v_and_b32 v6, 1, v4
    v_lshlrev_b32 v10, 1, v6
    v_or_b32 v10, v10, v9
    v_and_b32 v7, 3, v0
    v_lshlrev_b32 v7, 3, v7
    v_lshrrev_b32 v6, 2, v5
    v_lshl_add_u32 v65, v4, 3, v6
    v_lshl_add_u32 v65, v65, 7, v7
    v_xor_b32 v80, s46, v10
    v_lshl_add_u32 v65, v80, 5, v65
    v_lshl_add_u32 v6, v4, 2, v6
    v_lshl_add_u32 v72, v6, 7, v7
    v_lshl_add_u32 v72, v10, 5, v72
    v_lshl_add_u32 v81, v6, 8, v7
    v_and_b32 v80, 7, v6
    v_lshlrev_b32 v6, 4, v4
    v_lshl_add_u32 v88, v9, 13, v6
    v_lshlrev_b32 v89, 7, v4
    v_lshl_add_u32 v89, v9, 11, v89
    s_lshl_b32 s70, s47, 14
    s_add_u32 s70, s70, 262144
    s_lshl_b32 s53, s49, 11
    s_add_u32 s68, s70, s53
    s_bfe_u32 s53, s56, 0x30007
    s_lshl_b32 s53, s53, 8
    s_add_u32 s68, s68, s53
    s_lshl_b32 s54, s46, 6
    s_add_u32 s68, s68, s54
    s_lshl_b32 s53, s46, 9
    s_add_u32 s70, s70, s53
    s_lshr_b32 s51, s50, 1
    s_sub_u32 s51, s51, s49
    s_and_b32 s51, s51, 3
    s_mul_i32 s52, s47, 7
    s_add_u32 s52, s52, 1
    s_lshr_b32 s52, s52, 1
    s_add_u32 s52, s52, s51
    s_and_b32 s54, s47, 1
    s_add_u32 s54, s54, s51
    s_cmp_eq_u32 s54, 4
    s_cselect_b32 s52, 0x4000, s52
    s_lshl_b32 s53, s49, 1
    s_and_b32 s54, s50, 1
    s_add_u32 s53, s53, s54
    s_lshl_b32 s57, s53, 2
    s_add_u32 s57, s57, s46
    s_mul_i32 s57, s57, 57344
    s_lshl_b32 s54, s52, 7
    s_add_u32 s57, s57, s54
    s_mov_b32 s26, 1835008
    s_mov_b32 s27, 0x20000
    v_lshrrev_b32 v7, 3, v0
    v_mul_u32_u24 v13, 3584, v7
    v_and_b32 v6, 0x7f, v11
    v_add_u32 v13, v13, v6
    v_xor_b32 v14, 64, v13
    s_lshl_b32 s71, s47, 2
    s_add_u32 s75, s71, s49
    s_add_u32 s71, s71, s51
    s_lshl_b32 s71, s71, 12
    s_add_u32 s71, s71, 524288
    s_lshl_b32 s53, s53, 4
    s_add_u32 s69, s71, s53
    s_lshl_b32 s53, s46, 9
    s_add_u32 s69, s69, s53
    s_waitcnt vmcnt(5)
    v_lshlrev_b32 v104, 16, v20
    s_add_u32 m0, s61, 24576
    s_nop 0
    buffer_load_dwordx4 v13, s[24:27], s57 offen nt lds
    v_and_b32 v105, s62, v20
    v_lshlrev_b32 v106, 16, v21
    v_and_b32 v107, s62, v21
    v_lshlrev_b32 v108, 16, v22
    v_and_b32 v109, s62, v22
    v_lshlrev_b32 v110, 16, v23
    v_and_b32 v111, s62, v23
    v_lshlrev_b32 v112, 16, v24
    v_and_b32 v113, s62, v24
    v_lshlrev_b32 v114, 16, v25
    v_and_b32 v115, s62, v25
    v_lshlrev_b32 v116, 16, v26
    s_add_u32 m0, s61, 25600
    s_add_u32 s57, s57, 28672
    buffer_load_dwordx4 v14, s[24:27], s57 offen nt lds
    v_and_b32 v117, s62, v26
    v_lshlrev_b32 v118, 16, v27
    v_and_b32 v119, s62, v27
    v_pk_add_f32 v[130:131], v[104:105], v[106:107]
    v_pk_add_f32 v[132:133], v[108:109], v[110:111]
    v_pk_add_f32 v[134:135], v[112:113], v[114:115]
    v_pk_add_f32 v[136:137], v[116:117], v[118:119]
    v_pk_add_f32 v[130:131], v[130:131], v[132:133]
    v_pk_add_f32 v[134:135], v[134:135], v[136:137]
    v_add_f32 v122, v130, v131
    v_add_f32 v123, v134, v135
    v_cndmask_b32 v125, v123, v122, s[82:83]
    s_lshl2_add_u32 m0, s61, 90112
    s_add_u32 s59, s59, 0
    buffer_load_dwordx4 v16, s[8:11], s59 offen nt lds
    v_cndmask_b32 v124, v122, v123, s[82:83]
    s_waitcnt vmcnt(7)
    v_lshlrev_b32 v130, 16, v28
    v_add_f32_dpp v124, v125, v124 row_ror:8 row_mask:0xf bank_mask:0xf
    v_and_b32 v131, s62, v28
    v_lshlrev_b32 v132, 16, v29
    v_add_f32_dpp v124, v124, v124 quad_perm:[1,0,3,2] row_mask:0xf bank_mask:0xf
    v_and_b32 v133, s62, v29
    v_lshlrev_b32 v134, 16, v30
    v_add_f32_dpp v124, v124, v124 quad_perm:[2,3,0,1] row_mask:0xf bank_mask:0xf
    v_and_b32 v135, s62, v30
    v_lshlrev_b32 v136, 16, v31
    v_add_f32_dpp v124, v124, v124 row_half_mirror row_mask:0xf bank_mask:0xf
    s_lshl2_add_u32 m0, s61, 91136
    s_add_u32 s59, s59, 1024
    buffer_load_dwordx4 v17, s[8:11], s59 offen nt lds
    v_mov_b32 v125, v124
    v_and_b32 v137, s62, v31
    s_nop 0
    v_permlane16_swap_b32 v124, v125
    v_add_f32 v124, v124, v125
    v_mov_b32 v125, v124
    s_nop 1
    v_permlane32_swap_b32 v124, v125
    v_add_f32 v124, v124, v125
    v_mul_f32 v124, 0xbb000000, v124
    v_cvt_pk_bf16_f32 v126, v124, v124
    v_and_b32 v126, s62, v126
    v_mov_b32_dpp v120, v124 row_newbcast:0 row_mask:0xf bank_mask:0xf
    v_mov_b32_dpp v128, v124 row_newbcast:8 row_mask:0xf bank_mask:0xf
    s_lshl2_add_u32 m0, s61, 92160
    s_add_u32 s59, s59, 1024
    buffer_load_dwordx4 v18, s[8:11], s59 offen nt lds
    v_mov_b32_dpp v121, v124 row_newbcast:0 row_mask:0xf bank_mask:0xf
    v_mov_b32_dpp v129, v124 row_newbcast:8 row_mask:0xf bank_mask:0xf
    v_pk_add_f32 v[104:105], v[104:105], v[120:121]
    v_pk_add_f32 v[106:107], v[106:107], v[120:121]
    v_pk_add_f32 v[108:109], v[108:109], v[120:121]
    v_pk_add_f32 v[110:111], v[110:111], v[120:121]
    v_pk_add_f32 v[112:113], v[112:113], v[128:129]
    v_pk_add_f32 v[114:115], v[114:115], v[128:129]
    v_pk_add_f32 v[116:117], v[116:117], v[128:129]
    v_pk_add_f32 v[118:119], v[118:119], v[128:129]
    v_pk_mul_f32 v[120:121], v[104:105], v[104:105]
    v_pk_mul_f32 v[128:129], v[112:113], v[112:113]
    s_lshl2_add_u32 m0, s61, 93184
    s_add_u32 s59, s59, 1024
    buffer_load_dwordx4 v19, s[8:11], s59 offen nt lds
    v_pk_fma_f32 v[120:121], v[106:107], v[106:107], v[120:121]
    v_pk_fma_f32 v[128:129], v[114:115], v[114:115], v[128:129]
    v_pk_fma_f32 v[120:121], v[108:109], v[108:109], v[120:121]
    v_pk_fma_f32 v[128:129], v[116:117], v[116:117], v[128:129]
    v_pk_fma_f32 v[120:121], v[110:111], v[110:111], v[120:121]
    v_pk_fma_f32 v[128:129], v[118:119], v[118:119], v[128:129]
    v_add_f32 v122, v120, v121
    v_add_f32 v123, v128, v129
    v_cndmask_b32 v125, v123, v122, s[82:83]
    v_cndmask_b32 v124, v122, v123, s[82:83]
    v_mov_b32 v127, v126
    v_pk_add_f32 v[130:131], v[130:131], v[126:127]
    v_add_f32_dpp v124, v125, v124 row_ror:8 row_mask:0xf bank_mask:0xf
    v_pk_add_f32 v[132:133], v[132:133], v[126:127]
    v_pk_add_f32 v[134:135], v[134:135], v[126:127]
    v_add_f32_dpp v124, v124, v124 quad_perm:[1,0,3,2] row_mask:0xf bank_mask:0xf
    v_pk_add_f32 v[136:137], v[136:137], v[126:127]
    v_cvt_pk_bf16_f32 v28, v130, v131
    v_add_f32_dpp v124, v124, v124 quad_perm:[2,3,0,1] row_mask:0xf bank_mask:0xf
    v_cvt_pk_bf16_f32 v29, v132, v133
    v_cvt_pk_bf16_f32 v30, v134, v135
    v_add_f32_dpp v124, v124, v124 row_half_mirror row_mask:0xf bank_mask:0xf
    v_mov_b32 v125, v124
    v_cvt_pk_bf16_f32 v31, v136, v137
    v_lshlrev_b32 v130, 16, v28
    v_permlane16_swap_b32 v124, v125
    v_add_f32 v124, v124, v125
    v_mov_b32 v125, v124
    v_and_b32 v131, s62, v28
    v_lshlrev_b32 v132, 16, v29
    v_permlane32_swap_b32 v124, v125
    v_add_f32 v124, v124, v125
    v_and_b32 v133, s62, v29
    v_mul_f32 v124, 0x3b000000, v124
    v_cvt_pk_bf16_f32 v124, v124, v124
    v_lshlrev_b32 v124, 16, v124
    v_add_f32 v124, 0x3727c5ac, v124
    v_cvt_pk_bf16_f32 v124, v124, v124
    v_lshlrev_b32 v124, 16, v124
    v_sqrt_f32 v124, v124
    v_lshlrev_b32 v134, 16, v30
    v_cvt_pk_bf16_f32 v124, v124, v124
    v_lshlrev_b32 v124, 16, v124
    v_rcp_f32 v128, v124
    v_and_b32 v135, s62, v30
    v_lshlrev_b32 v136, 16, v31
    v_and_b32 v137, s62, v31
    v_mov_b32 v129, v128
    v_pk_mul_f32 v[130:131], v[130:131], v[128:129]
    v_pk_mul_f32 v[132:133], v[132:133], v[128:129]
    v_pk_mul_f32 v[134:135], v[134:135], v[128:129]
    v_pk_mul_f32 v[136:137], v[136:137], v[128:129]
    v_cvt_pk_bf16_f32 v28, v130, v131
    v_cvt_pk_bf16_f32 v29, v132, v133
    v_cvt_pk_bf16_f32 v30, v134, v135
    v_cvt_pk_bf16_f32 v31, v136, v137
    ds_write_b128 v96, v[28:31] offset:0
    ds_write_b32 v83, v83 offset:5760
    s_getreg_b32 s88, hwreg(HW_REG_XCC_ID, 0, 4)
    s_waitcnt lgkmcnt(0)
    s_add_u32 s84, s44, 0x9e3779b9
    s_lshr_b32 s85, s84, 8
    s_lshr_b32 s86, s84, 16
    s_lshr_b32 s87, s84, 24
    s_xor_b32 s89, s84, s88
    s_mov_b32 s90, s89
    s_mov_b32 s34, 1835008
    s_mov_b32 s35, 0x20000
    s_mov_b32 s14, 33554432
    s_mov_b32 s15, 0x20000
    s_mov_b32 s30, 3584
    s_mov_b32 s31, 0x20000
    s_lshl_b32 s67, s64, 2
    s_xor_b32 s67, s67, s50
    s_and_b32 s67, s67, 7
    s_lshl_b32 s60, s52, 2
    s_add_u32 s60, s60, s46
    s_lshl_b32 s60, s60, 14
    s_lshl_b32 s53, s67, 7
    s_add_u32 s60, s60, s53
    v_lshlrev_b32 v6, 1, v4
    v_and_b32 v7, 7, v0
    v_xor_b32 v6, v6, v7
    v_lshlrev_b32 v6, 4, v6
    v_lshrrev_b32 v64, 3, v0
    v_lshl_add_u32 v64, v64, 10, v6
    v_lshlrev_b32 v6, 4, v4
    v_lshl_add_u32 v6, v9, 6, v6
    v_lshlrev_b32 v91, 4, v7
    v_lshl_add_u32 v91, v6, 3, v91
    v_lshrrev_b32 v85, 1, v6
    v_and_b32 v7, 1, v0
    v_lshl_add_u32 v85, v7, 2, v85
    v_and_b32 v6, 2, v0
    v_add_u32 v85, v85, v6
    v_and_b32 v6, 1, v4
    s_waitcnt vmcnt(6)
    s_barrier
    ds_read_b128 v[104:107], v8 offset:0
    ds_read_b64_tr_b16 v[120:121], v65 offset:8192
    ds_read_b64_tr_b16 v[122:123], v65 offset:8704
    ds_read_b128 v[108:111], v8 offset:1024
    ds_read_b64_tr_b16 v[124:125], v65 offset:12288
    ds_read_b64_tr_b16 v[126:127], v65 offset:12800
    ds_read_b128 v[112:115], v8 offset:2048
    ds_read_b64_tr_b16 v[128:129], v65 offset:16384
    ds_read_b64_tr_b16 v[130:131], v65 offset:16896
    ds_read_b128 v[116:119], v8 offset:3072
    ds_read_b64_tr_b16 v[132:133], v65 offset:20480
    ds_read_b64_tr_b16 v[134:135], v65 offset:20992
    s_waitcnt lgkmcnt(9)
    v_mfma_f32_16x16x32_bf16 v[136:139], v[120:123], v[104:107], 0
    s_waitcnt lgkmcnt(6)
    v_mfma_f32_16x16x32_bf16 v[136:139], v[124:127], v[108:111], v[136:139]
    s_waitcnt lgkmcnt(3)
    v_mfma_f32_16x16x32_bf16 v[136:139], v[128:131], v[112:115], v[136:139]
    s_waitcnt lgkmcnt(0)
    v_mfma_f32_16x16x32_bf16 v[136:139], v[132:135], v[116:119], v[136:139]
    s_mov_b32 exec_lo, 0x01010101
    s_mov_b32 exec_hi, 0x01010101
    s_nop 5
    v_bfi_b32 v136, v82, s89, v136
    v_bfi_b32 v137, v82, s85, v137
    v_bfi_b32 v138, v82, s86, v138
    v_bfi_b32 v139, v82, s87, v139
    buffer_store_dwordx4 v[136:139], v88, s[40:43], s68 offen
    ds_write_b128 v84, v[136:139] offset:5888
    s_mov_b64 exec, -1
    s_mov_b32 s91, 0
    v_lshlrev_b32 v86, 1, v6
    s_lshl2_add_u32 m0, s61, 94208
    s_add_u32 s59, s59, 62464
    buffer_load_dwordx4 v16, s[8:11], s59 offen nt lds
    v_lshl_add_u32 v86, v7, 2, v86
    v_lshlrev_b32 v6, 1, v4
    v_xor_b32 v6, v6, v5
    v_lshlrev_b32 v6, 4, v6
    v_lshl_add_u32 v66, v4, 8, v6
    v_xor_b32 v67, 0x80, v66
    s_mul_i32 s74, s64, 65536
    s_add_u32 s74, s74, s58
    s_mul_i32 s53, s63, 2048
    s_lshl2_add_u32 m0, s61, 95232
    s_add_u32 s59, s59, 1024
    buffer_load_dwordx4 v17, s[8:11], s59 offen nt lds
    s_add_u32 s74, s74, s53
    v_lshrrev_b32 v100, 1, v0
    v_lshlrev_b32 v100, 7, v100
    v_lshl_add_u32 v100, v7, 4, v100
    v_lshrrev_b32 v6, 5, v0
    v_and_b32 v7, 31, v0
    v_lshlrev_b32 v90, 12, v6
    v_lshl_add_u32 v90, v7, 4, v90
    v_lshlrev_b32 v92, 2, v6
    s_lshl2_add_u32 m0, s61, 96256
    s_add_u32 s59, s59, 1024
    buffer_load_dwordx4 v18, s[8:11], s59 offen nt lds
    v_lshl_add_u32 v92, v7, 3, v92
    s_lshl_b32 s55, s52, 7
    s_lshl_b32 s53, s64, 6
    s_add_u32 s55, s55, s53
    s_lshl_b32 s56, s65, 10
    s_lshl_b32 s53, s47, 7
    s_add_u32 s56, s56, s53
    s_lshl_b32 s53, s66, 3
    s_add_u32 s56, s56, s53
    s_lshl2_add_u32 m0, s61, 97280
    s_add_u32 s59, s59, 1024
    buffer_load_dwordx4 v19, s[8:11], s59 offen nt lds
    s_lshl_b32 s53, s65, 13
    s_add_u32 s70, s70, s53
    s_lshl_b32 s53, s63, 11
    s_add_u32 s71, s71, s53
    s_lshl_b32 s53, s64, 10
    s_add_u32 s71, s71, s53
    s_lshl_b32 s53, s48, 2
    s_add_u32 s53, s53, s46
    s_lshl_b32 s54, s47, 7
    s_add_u32 s54, s54, s53
    s_lshl_b32 s54, s54, 9
    s_add_u32 s54, s54, 1048576
    v_lshlrev_b32 v87, 7, v0
    v_add_u32 v87, s54, v87
    s_and_b32 s53, s53, 15
    s_lshl_b32 s54, s47, 4
    s_add_u32 s53, s53, s54
    s_lshl_b32 s53, s53, 7
    s_add_u32 s53, s53, 786432
    v_writelane_b32 v87, s53, 4
    buffer_load_ushort v101, v85, s[28:31], s55 offen
    buffer_load_ushort v102, v86, s[4:7], s56 offen
    s_mov_b32 exec_lo, 31
    s_mov_b32 exec_hi, 0
    buffer_load_dword v87, v87, s[40:43], 0 offen
    s_mov_b64 exec, -1
    s_waitcnt vmcnt(12)
    s_waitcnt lgkmcnt(0)
    s_barrier
    ds_read_b64_tr_b16 v[140:141], v65 offset:24576
    ds_read_b64_tr_b16 v[142:143], v65 offset:25088
    ds_read_b64_tr_b16 v[144:145], v65 offset:28672
    ds_read_b64_tr_b16 v[146:147], v65 offset:29184
    s_waitcnt lgkmcnt(2)
    v_mfma_f32_16x16x32_bf16 v[170:173], v[140:143], v[104:107], 0
    s_waitcnt lgkmcnt(0)
    v_mfma_f32_16x16x32_bf16 v[170:173], v[144:147], v[108:111], v[170:173]
    s_mov_b32 s22, 4194304
    s_mov_b32 s23, 0x20000
    s_mov_b32 s38, 2048
    s_mov_b32 s39, 0x20000
    v_xor_b32 v69, 64, v68
    v_xor_b32 v70, 0x80, v68
    s_mov_b32 exec_lo, 0x01010101
    s_mov_b32 exec_hi, 0x01010101
    v_bfi_b32 v170, v82, s90, v170
    v_bfi_b32 v171, v82, s85, v171
    v_bfi_b32 v172, v82, s86, v172
    v_bfi_b32 v173, v82, s87, v173
    buffer_store_dwordx4 v[170:173], v89, s[40:43], s69 offen
    s_mov_b64 exec, -1
    v_xor_b32 v71, 0xc0, v68
    v_and_b32 v7, 3, v0
    v_mul_u32_u24 v93, 320, v7
    v_lshl_add_u32 v93, v4, 4, v93
    v_lshlrev_b32 v95, 4, v7
    v_lshlrev_b32 v97, 13, v7
    v_lshl_add_u32 v97, v4, 8, v97
    v_bfe_u32 v6, v0, 2, 1
    v_lshl_add_u32 v97, v6, 10, v97
    s_lshl_b32 s54, s46, 2
    s_add_u32 m0, s61, 57344
    s_add_i32 s74, s74, 0
    buffer_load_dwordx4 v66, s[12:15], s74 offen nt lds
    v_add_u32 v94, s54, v95
    s_lshl_b32 s54, s64, 12
    v_add_u32 v72, s54, v72
    v_xor_b32 v73, 32, v72
    v_xor_b32 v74, 64, v72
    v_xor_b32 v75, 0x60, v72
    v_add_u32 v76, s54, v72
    v_add_u32 v77, s54, v73
    v_add_u32 v78, s54, v74
    v_add_u32 v79, s54, v75
    s_add_u32 m0, s61, 58368
    s_add_i32 s74, s74, 1024
    buffer_load_dwordx4 v67, s[12:15], s74 offen nt lds
    s_lshl_b32 s54, s46, 1
    v_xor_b32 v80, s54, v80
    v_lshl_add_u32 v80, v80, 5, v81
    v_add_u32 v80, 57344, v80
    v_xor_b32 v81, 32, v80
    s_mul_i32 s54, s46, 320
    v_add_u32 v92, s54, v92
    v_lshl_add_u32 v98, v4, 2, v5
    v_and_b32 v98, 15, v98
    v_lshlrev_b32 v98, 4, v98
    s_add_u32 m0, s61, 65536
    s_add_i32 s74, s74, 130048
    s_xor_b32 s74, s74, 0
    buffer_load_dwordx4 v66, s[12:15], s74 offen nt lds
    v_lshlrev_b32 v99, 3, v5
    v_lshl_add_u32 v99, v4, 13, v99
    s_lshl_b32 s78, s75, 1
    s_add_u32 s78, s78, s64
    s_lshl_b32 s78, s78, 7
    s_lshl_b32 s54, s67, 1
    s_add_u32 s54, s54, s63
    s_lshl_b32 s54, s54, 15
    s_add_u32 s78, s78, s54
    s_add_u32 s78, s78, 1572864
    s_add_u32 m0, s61, 66560
    s_add_i32 s74, s74, 1024
    buffer_load_dwordx4 v67, s[12:15], s74 offen nt lds
    s_lshl_b32 s75, s75, 4
    s_add_u32 s75, s75, s46
    s_lshl_b32 s75, s75, 13
    s_xor_b32 s54, s50, 4
    s_lshl_b32 s54, s54, 7
    s_add_u32 s52, s75, s54
    s_add_u32 s52, s52, 65536
    s_lshl_b32 s54, s50, 7
    s_add_u32 s75, s75, s54
    s_lshl_b32 s73, s47, 1
    buffer_load_dwordx4 v[112:115], v90, s[40:43], s70 offen sc1
    buffer_load_dwordx4 v[116:119], v90, s[40:43], s70 offen offset:2048 sc1
    s_add_u32 s73, s73, s65
    s_lshl_b32 s72, s73, 2
    s_add_u32 s72, s72, s46
    s_lshl_b32 s72, s72, 8
    s_lshl_b32 s54, s66, 4
    s_add_u32 s72, s72, s54
    s_add_u32 s72, s72, 786432
    s_lshl_b32 s73, s73, 15
    s_add_u32 s73, s73, s54
    s_lshl_b32 s54, s46, 11
    s_add_u32 m0, s61, 73728
    s_add_i32 s74, s74, 130048
    s_xor_b32 s74, s74, 12288
    buffer_load_dwordx4 v66, s[12:15], s74 offen nt lds
    s_add_u32 s73, s73, s54
    s_add_u32 s73, s73, 1048576
    s_lshl_b32 s76, s47, 1
    s_add_u32 s76, s76, s63
    s_lshl_b32 s76, s76, 2
    s_add_u32 s76, s76, s49
    s_lshl_b32 s77, s76, 8
    s_add_u32 s77, s77, 786432
    s_lshl_b32 s76, s76, 13
    s_lshl_b32 s54, s64, 12
    s_add_u32 m0, s61, 74752
    s_add_i32 s74, s74, 1024
    buffer_load_dwordx4 v67, s[12:15], s74 offen nt lds
    s_add_u32 s76, s76, s54
    s_add_u32 s76, s76, 1048576
    s_lshl_b32 s79, s47, 3
    s_lshr_b32 s54, s48, 2
    s_add_u32 s79, s79, s54
    s_lshl_b32 s79, s79, 13
    s_and_b32 s54, s48, 3
    s_lshl_b32 s54, s54, 5
    s_add_u32 s79, s79, s54
    s_add_u32 s79, s79, 1572864
    s_add_u32 m0, s61, 81920
    s_add_i32 s74, s74, 130048
    s_xor_b32 s74, s74, 0
    buffer_load_dwordx4 v66, s[12:15], s74 offen nt lds
    s_add_u32 s80, s79, 4096
    s_mov_b32 s51, 0xffffff00
    v_mov_b32 v168, 0x3db504f3
    v_mov_b32 v169, 0x3db504f3
    s_mov_b32 s55, 0x3fb8aa3b
    s_mov_b32 s59, 0x3f317218
    s_mov_b32 s58, 0xc038aa3b
    s_mov_b32 s82, 0x55555555
    s_mov_b32 s83, 0x55555555
    s_mov_b32 s44, 0x33333333
    s_add_u32 m0, s61, 82944
    s_add_i32 s74, s74, 1024
    buffer_load_dwordx4 v67, s[12:15], s74 offen nt lds
    s_mov_b32 s45, 0x33333333
    v_mov_b32 v166, s84
    v_mov_b32 v167, s84
    v_mov_b32 v152, 0x3f803f80
    v_mov_b32 v156, s84
    v_mov_b32 v160, 0
    v_mov_b32 v153, 0x3f803f80
    v_mov_b32 v157, s84
    v_mov_b32 v161, 0
    v_mov_b32 v154, 0x3f803f80
    v_mov_b32 v158, s84
    v_mov_b32 v162, 0
    v_mov_b32 v155, 0x3f803f80
    v_mov_b32 v159, s84
    v_mov_b32 v163, 0
    s_waitcnt lgkmcnt(0)
    buffer_load_dwordx4 v[120:123], v91, s[40:43], s71 offen sc1
    s_waitcnt vmcnt(15)
    ds_read_b128 v[32:35], v68 offset:0
    ds_read_b128 v[36:39], v69 offset:0
    ds_read_b128 v[40:43], v70 offset:0
    ds_read_b128 v[44:47], v71 offset:0
    ds_read_b128 v[48:51], v68 offset:4096
    ds_read_b128 v[52:55], v69 offset:4096
    ds_read_b128 v[56:59], v70 offset:4096
    ds_read_b128 v[60:63], v71 offset:4096
    s_waitcnt vmcnt(5)
L_chk1:
    v_xor_b32 v6, s89, v112
    v_xor_b32 v7, s89, v116
    v_bitop3_b32 v6, v113, s85, v6 bitop3:0xbe
    v_bitop3_b32 v7, v117, s85, v7 bitop3:0xbe
    v_bitop3_b32 v6, v114, s86, v6 bitop3:0xbe
    v_bitop3_b32 v7, v118, s86, v7 bitop3:0xbe
    v_bitop3_b32 v6, v115, s87, v6 bitop3:0xbe
    v_bitop3_b32 v7, v119, s87, v7 bitop3:0xbe
    v_bitop3_b32 v6, v6, v7, v82 bitop3:0xa8
    v_cmp_ne_u32 vcc, 0, v6
    v_and_b32 v140, s51, v112
    v_and_b32 v141, s51, v113
    v_and_b32 v142, s51, v114
    v_and_b32 v143, s51, v115
    v_and_b32 v144, s51, v116
    v_and_b32 v145, s51, v117
    v_and_b32 v146, s51, v118
    v_and_b32 v147, s51, v119
    s_cbranch_vccnz L_retry1
L_ok1:
    v_pk_add_f32 v[140:141], v[140:141], v[144:145]
    v_pk_add_f32 v[142:143], v[142:143], v[146:147]
    s_nop 1
    v_permlane32_swap_b32 v140, v142
    v_permlane32_swap_b32 v141, v143
    v_add_f32 v140, v140, v142
    v_add_f32 v141, v141, v143
    v_cvt_pk_bf16_f32 v140, v140, v141
    ds_write_b32 v92, v140 offset:4096
    s_add_u32 m0, s61, 32768
    s_nop 0
    buffer_load_dwordx4 v64, s[32:35], s60 offen nt lds
    s_add_u32 m0, s61, 33792
    s_add_u32 s60, s60, 8192
    buffer_load_dwordx4 v64, s[32:35], s60 offen nt lds
    s_waitcnt lgkmcnt(0)
    s_barrier
    ds_read_b32 v7, v83 offset:5760
    ds_read_b128 v[124:127], v93 offset:4096
    ds_read_b128 v[128:131], v93 offset:4160
    ds_read_b128 v[132:135], v93 offset:4224
    ds_read_b128 v[136:139], v93 offset:4288
    s_waitcnt lgkmcnt(3)
    v_mfma_f32_16x16x32_bf16 v[140:143], v[32:35], v[124:127], 0
    v_mfma_f32_16x16x32_bf16 v[144:147], v[48:51], v[124:127], 0
    s_waitcnt lgkmcnt(2)
    v_mfma_f32_16x16x32_bf16 v[140:143], v[36:39], v[128:131], v[140:143]
    v_mfma_f32_16x16x32_bf16 v[144:147], v[52:55], v[128:131], v[144:147]
    s_waitcnt lgkmcnt(1)
    v_mfma_f32_16x16x32_bf16 v[140:143], v[40:43], v[132:135], v[140:143]
    v_mfma_f32_16x16x32_bf16 v[144:147], v[56:59], v[132:135], v[144:147]
    s_waitcnt lgkmcnt(0)
    v_mfma_f32_16x16x32_bf16 v[140:143], v[44:47], v[136:139], v[140:143]
    v_mfma_f32_16x16x32_bf16 v[144:147], v[60:63], v[136:139], v[144:147]
    v_readfirstlane_b32 s92, v7
    s_lshr_b32 m0, s61, 1
    s_add_u32 m0, m0, 40960
    s_add_u32 s75, s75, 0
    buffer_load_dwordx4 v64, s[20:23], s75 offen nt lds
    s_nop 1
    v_max3_f32 v6, v140, v141, v142
    v_max3_f32 v7, v143, v144, v145
    v_max3_f32 v6, v6, v146, v147
    v_max_f32 v6, v6, v7
    v_mov_b32 v7, v6
    v_cvt_pk_bf16_f32 v104, v140, v141
    v_cvt_pk_bf16_f32 v105, v142, v143
    v_permlane16_swap_b32 v6, v7
    v_max_f32 v6, v6, v7
    v_mov_b32 v7, v6
    v_cvt_pk_bf16_f32 v106, v144, v145
    v_cvt_pk_bf16_f32 v107, v146, v147
    v_permlane32_swap_b32 v6, v7
    v_max_f32 v6, v6, v7
    ds_write_b32 v94, v6 offset:5632
    v_lshlrev_b32 v140, 16, v104
    v_and_b32 v141, s62, v104
    v_lshlrev_b32 v142, 16, v105
    v_and_b32 v143, s62, v105
    v_lshlrev_b32 v144, 16, v106
    v_and_b32 v145, s62, v106
    v_lshlrev_b32 v146, 16, v107
    v_and_b32 v147, s62, v107
    v_pk_mul_f32 v[140:141], v[140:141], v[168:169]
    v_pk_mul_f32 v[142:143], v[142:143], v[168:169]
    v_pk_mul_f32 v[144:145], v[144:145], v[168:169]
    v_pk_mul_f32 v[146:147], v[146:147], v[168:169]
    s_cmp_eq_u32 s92, 0
    s_cbranch_scc0 L_mixed
L_mixback:
    s_waitcnt lgkmcnt(0)
    s_barrier
    ds_read_b128 v[108:111], v95 offset:5632
    v_cvt_pk_bf16_f32 v104, v140, v141
    v_cvt_pk_bf16_f32 v105, v142, v143
    v_cvt_pk_bf16_f32 v106, v144, v145
    v_cvt_pk_bf16_f32 v107, v146, v147
    v_lshlrev_b32 v140, 16, v104
    v_and_b32 v141, s62, v104
    v_lshlrev_b32 v142, 16, v105
    v_and_b32 v143, s62, v105
    v_lshlrev_b32 v144, 16, v106
    v_and_b32 v145, s62, v106
    v_lshlrev_b32 v146, 16, v107
    v_and_b32 v147, s62, v107
    s_waitcnt lgkmcnt(0)
    v_max3_f32 v6, v108, v109, v110
    v_max_f32 v6, v6, v111
    v_cvt_pk_bf16_f32 v6, v6, v6
    v_lshlrev_b32 v6, 16, v6
    v_mul_f32 v6, v6, v168
    v_cvt_pk_bf16_f32 v6, v6, v6
    v_lshlrev_b32 v6, 16, v6
    v_mul_f32 v164, s55, v6
    v_fma_f32 v140, v140, s55, -v164
    v_fma_f32 v141, v141, s55, -v164
    v_fma_f32 v142, v142, s55, -v164
    v_fma_f32 v143, v143, s55, -v164
    v_fma_f32 v144, v144, s55, -v164
    v_fma_f32 v145, v145, s55, -v164
    v_fma_f32 v146, v146, s55, -v164
    v_fma_f32 v147, v147, s55, -v164
    v_exp_f32 v140, v140
    v_exp_f32 v141, v141
    v_exp_f32 v142, v142
    v_exp_f32 v143, v143
    v_exp_f32 v144, v144
    v_exp_f32 v145, v145
    v_exp_f32 v146, v146
    v_exp_f32 v147, v147
    v_cvt_pk_bf16_f32 v104, v140, v141
    v_cvt_pk_bf16_f32 v105, v142, v143
    v_cvt_pk_bf16_f32 v106, v144, v145
    v_cvt_pk_bf16_f32 v107, v146, v147
    ds_write_b128 v96, v[104:107] offset:0
    s_lshr_b32 m0, s61, 1
    s_add_u32 m0, m0, 49152
    s_add_u32 s52, s52, 0
    buffer_load_dwordx4 v64, s[20:23], s52 offen nt lds
    s_lshr_b32 m0, s61, 1
    s_add_u32 m0, m0, 45056
    s_add_u32 s75, s75, 32768
    buffer_load_dwordx4 v64, s[20:23], s75 offen nt lds
    s_lshr_b32 m0, s61, 1
    s_add_u32 m0, m0, 53248
    s_add_u32 s52, s52, 32768
    buffer_load_dwordx4 v64, s[20:23], s52 offen nt lds
    s_mov_b32 exec_lo, 0x00010001
    s_mov_b32 exec_hi, 0x00010001
    buffer_load_dword v87, v99, s[40:43], s78 offen
    s_mov_b64 exec, -1
    v_mov_b32 v6, 0
    v_lshlrev_b32 v101, 16, v101
    s_lshl_b32 s53, 1, s46
    s_cmp_eq_u32 s92, 0
    s_waitcnt vmcnt(14)
    s_waitcnt lgkmcnt(0)
    s_barrier
    ds_read_b128 v[124:127], v8 offset:0
    ds_read_b128 v[128:131], v8 offset:1024
    ds_read_b128 v[132:135], v8 offset:2048
    ds_read_b128 v[136:139], v8 offset:3072
    ds_read_b64_tr_b16 v[32:33], v80 offset:0
    ds_read_b64_tr_b16 v[34:35], v80 offset:4096
    ds_read_b64_tr_b16 v[36:37], v81 offset:0
    ds_read_b64_tr_b16 v[38:39], v81 offset:4096
    ds_read_b64_tr_b16 v[40:41], v80 offset:8192
    ds_read_b64_tr_b16 v[42:43], v80 offset:12288
    ds_read_b64_tr_b16 v[44:45], v81 offset:8192
    ds_read_b64_tr_b16 v[46:47], v81 offset:12288
    s_waitcnt lgkmcnt(11)
    v_mfma_f32_16x16x32_bf16 v[140:143], v[152:155], v[124:127], 0
    s_waitcnt lgkmcnt(10)
    v_mfma_f32_16x16x32_bf16 v[140:143], v[152:155], v[128:131], v[140:143]
    s_waitcnt lgkmcnt(9)
    v_mfma_f32_16x16x32_bf16 v[140:143], v[152:155], v[132:135], v[140:143]
    s_waitcnt lgkmcnt(8)
    v_mfma_f32_16x16x32_bf16 v[140:143], v[152:155], v[136:139], v[140:143]
    s_waitcnt lgkmcnt(6)
    v_mfma_f32_16x16x32_bf16 v[206:209], v[32:35], v[124:127], 0
    s_waitcnt lgkmcnt(4)
    v_mfma_f32_16x16x32_bf16 v[210:213], v[36:39], v[124:127], 0
    s_waitcnt lgkmcnt(2)
    v_mfma_f32_16x16x32_bf16 v[206:209], v[40:43], v[128:131], v[206:209]
    s_waitcnt lgkmcnt(0)
    v_mfma_f32_16x16x32_bf16 v[210:213], v[44:47], v[128:131], v[210:213]
    s_waitcnt vmcnt(10)
    s_barrier
    ds_read_b64_tr_b16 v[48:49], v80 offset:16384
    ds_read_b64_tr_b16 v[50:51], v80 offset:20480
    ds_read_b64_tr_b16 v[52:53], v81 offset:16384
    ds_read_b64_tr_b16 v[54:55], v81 offset:20480
    v_mov_b32 v165, v140
    s_mov_b32 exec_lo, s53
    s_mov_b32 exec_hi, 0
    s_cbranch_scc0 L_mlmix
    buffer_store_dwordx4 v[164:167], v6, s[40:43], s72 offen
L_mlback:
    s_mov_b64 exec, -1
    s_waitcnt lgkmcnt(2)
    v_mfma_f32_16x16x32_bf16 v[206:209], v[48:51], v[132:135], v[206:209]
    s_waitcnt lgkmcnt(0)
    v_mfma_f32_16x16x32_bf16 v[210:213], v[52:55], v[132:135], v[210:213]
    s_waitcnt vmcnt(9)
    s_barrier
    ds_read_b64_tr_b16 v[56:57], v80 offset:24576
    ds_read_b64_tr_b16 v[58:59], v80 offset:28672
    ds_read_b64_tr_b16 v[60:61], v81 offset:24576
    ds_read_b64_tr_b16 v[62:63], v81 offset:28672
    s_waitcnt lgkmcnt(2)
    v_mfma_f32_16x16x32_bf16 v[206:209], v[56:59], v[136:139], v[206:209]
    s_waitcnt lgkmcnt(0)
    v_mfma_f32_16x16x32_bf16 v[210:213], v[60:63], v[136:139], v[210:213]
    s_mov_b32 exec_lo, 0x000f000f
    s_mov_b32 exec_hi, 0x000f000f
    s_mov_b32 s91, 0
    s_nop 2
    v_cvt_pk_bf16_f32 v158, v206, v207
    v_cvt_pk_bf16_f32 v159, v208, v209
    s_mov_b32 exec_lo, 0x00f000f0
    s_mov_b32 exec_hi, 0x00f000f0
    v_cvt_pk_bf16_f32 v156, v210, v211
    v_cvt_pk_bf16_f32 v157, v212, v213
    s_mov_b32 exec_lo, 0x00ff00ff
    s_mov_b32 exec_hi, 0x00ff00ff
    s_cbranch_scc0 L_psmix
    buffer_store_dwordx4 v[156:159], v97, s[40:43], s73 offen
L_psback:
    s_mov_b64 exec, -1
    s_waitcnt vmcnt(9)
L_chkh:
    v_xor_b32 v6, s90, v120
    v_bitop3_b32 v6, v121, s85, v6 bitop3:0xbe
    v_bitop3_b32 v6, v122, s86, v6 bitop3:0xbe
    v_bitop3_b32 v6, v123, s87, v6 bitop3:0xbe
    v_and_b32 v6, v6, v82
    v_cmp_ne_u32 vcc, 0, v6
    v_and_b32 v140, s51, v120
    v_and_b32 v141, s51, v121
    v_and_b32 v142, s51, v122
    v_and_b32 v143, s51, v123
    s_cbranch_vccnz L_retryh
L_okh:
    v_cndmask_b32 v144, v140, v142, s[82:83]
    v_cndmask_b32 v145, v141, v143, s[82:83]
    v_cndmask_b32 v146, v142, v140, s[82:83]
    v_cndmask_b32 v147, v143, v141, s[82:83]
    s_nop 0
    v_add_f32_dpp v146, v144, v146 quad_perm:[1,0,3,2] row_mask:0xf bank_mask:0xf
    v_add_f32_dpp v147, v145, v147 quad_perm:[1,0,3,2] row_mask:0xf bank_mask:0xf
    v_cndmask_b32 v144, v146, v147, s[44:45]
    v_cndmask_b32 v140, v147, v146, s[44:45]
    s_nop 1
    v_add_f32_dpp v140, v144, v140 quad_perm:[2,3,0,1] row_mask:0xf bank_mask:0xf
    s_nop 1
    v_add_f32_dpp v140, v140, v140 row_shl:4 row_mask:0xf bank_mask:0xf
    v_cvt_pk_bf16_f32 v140, v140, v140
    v_lshlrev_b32 v140, 16, v140
    v_add_f32 v140, v140, v101
    v_cvt_pk_bf16_f32 v140, v140, v140
    v_lshlrev_b32 v140, 16, v140
    v_mul_f32 v141, -abs(v140), s55
    v_exp_f32 v141, v141
    s_nop 0
    v_cvt_pk_bf16_f32 v141, v141, v141
    v_lshlrev_b32 v141, 16, v141
    v_add_f32 v142, 1.0, v141
    v_add_f32 v143, -1.0, v142
    v_log_f32 v142, v142
    v_rcp_f32 v145, v143
    v_cmp_eq_f32 vcc, 0, v143
    v_mul_f32 v142, s59, v142
    v_mul_f32 v145, v145, v141
    v_mul_f32 v142, v142, v145
    v_cndmask_b32 v142, v142, v141, vcc
    v_cvt_pk_bf16_f32 v142, v142, v142
    v_lshlrev_b32 v142, 16, v142
    v_max_f32 v141, 0, v140
    v_add_f32 v142, v142, v141
    v_cvt_pk_bf16_f32 v142, v142, v142
    v_lshlrev_b32 v142, 16, v142
    v_mul_f32 v141, s58, v142
    v_exp_f32 v141, v141
    v_cmp_gt_f32 vcc, 0x3a800000, v142
    v_add_f32 v143, 1.0, v141
    v_rcp_f32 v143, v143
    v_sub_f32 v141, 1.0, v141
    v_mul_f32 v141, v141, v143
    v_cndmask_b32 v141, v141, v142, vcc
    v_cvt_pk_bf16_f32 v141, v141, v141
    v_lshlrev_b32 v141, 16, v141
    v_mul_f32 v141, v141, v140
    s_nop 1
    v_mov_b32_dpp v142, v141 quad_perm:[2,3,0,1] row_mask:0xf bank_mask:0xf
    v_cvt_pk_bf16_f32 v142, v141, v142
    s_nop 1
    v_mov_b32_dpp v160, v142 quad_perm:[0,1,2,3] row_mask:0xf bank_mask:0x1
    v_mov_b32_dpp v161, v142 row_shl:1 row_mask:0xf bank_mask:0x1
    v_mov_b32_dpp v162, v142 row_shl:8 row_mask:0xf bank_mask:0x1
    v_mov_b32_dpp v163, v142 row_shl:9 row_mask:0xf bank_mask:0x1
    s_waitcnt vmcnt(7)
    s_barrier
    ds_read_b64_tr_b16 v[174:175], v72 offset:32768
    ds_read_b64_tr_b16 v[176:177], v72 offset:34816
    ds_read_b64_tr_b16 v[178:179], v73 offset:32768
    ds_read_b64_tr_b16 v[180:181], v73 offset:34816
    ds_read_b64_tr_b16 v[182:183], v74 offset:32768
    ds_read_b64_tr_b16 v[184:185], v74 offset:34816
    ds_read_b64_tr_b16 v[186:187], v75 offset:32768
    ds_read_b64_tr_b16 v[188:189], v75 offset:34816
    s_mov_b32 s91, 0
    v_mov_b32 v157, s84
    v_lshlrev_b32 v102, 16, v102
    s_waitcnt lgkmcnt(6)
    v_mfma_f32_16x16x32_bf16 v[190:193], v[160:163], v[174:177], 0
    s_waitcnt lgkmcnt(4)
    v_mfma_f32_16x16x32_bf16 v[194:197], v[160:163], v[178:181], 0
    s_waitcnt lgkmcnt(2)
    v_mfma_f32_16x16x32_bf16 v[198:201], v[160:163], v[182:185], 0
    s_waitcnt lgkmcnt(0)
    v_mfma_f32_16x16x32_bf16 v[202:205], v[160:163], v[186:189], 0
    s_waitcnt vmcnt(5)
    buffer_load_dwordx4 v[124:127], v8, s[40:43], s76 offen offset:0 sc1
    buffer_load_dwordx4 v[128:131], v8, s[40:43], s76 offen offset:1024 sc1
    buffer_load_dwordx4 v[132:135], v8, s[40:43], s76 offen offset:2048 sc1
    buffer_load_dwordx4 v[136:139], v8, s[40:43], s76 offen offset:3072 sc1
    buffer_load_dwordx4 v[112:115], v98, s[40:43], s77 offen sc1
    s_barrier
    ds_read_b64_tr_b16 v[32:33], v76 offset:40960
    ds_read_b64_tr_b16 v[34:35], v76 offset:43008
    ds_read_b64_tr_b16 v[36:37], v77 offset:40960
    ds_read_b64_tr_b16 v[38:39], v77 offset:43008
    ds_read_b64_tr_b16 v[40:41], v78 offset:40960
    ds_read_b64_tr_b16 v[42:43], v78 offset:43008
    ds_read_b64_tr_b16 v[44:45], v79 offset:40960
    ds_read_b64_tr_b16 v[46:47], v79 offset:43008
    s_waitcnt vmcnt(8)
    s_barrier
    ds_read_b64_tr_b16 v[48:49], v76 offset:45056
    ds_read_b64_tr_b16 v[50:51], v76 offset:47104
    ds_read_b64_tr_b16 v[52:53], v77 offset:45056
    ds_read_b64_tr_b16 v[54:55], v77 offset:47104
    ds_read_b64_tr_b16 v[56:57], v78 offset:45056
    ds_read_b64_tr_b16 v[58:59], v78 offset:47104
    ds_read_b64_tr_b16 v[60:61], v79 offset:45056
    ds_read_b64_tr_b16 v[62:63], v79 offset:47104
    s_waitcnt vmcnt(0)
L_chk2:
    s_waitcnt lgkmcnt(8)
    v_mfma_f32_16x16x32_bf16 v[214:217], v[126:129], v[32:35], 0
    v_max_f32_dpp v6, v112, v112 row_ror:1 row_mask:0xf bank_mask:0xf
    v_xor_b32 v174, s84, v125
    v_mfma_f32_16x16x32_bf16 v[218:221], v[126:129], v[36:39], 0
    v_max_f32_dpp v6, v6, v6 row_ror:2 row_mask:0xf bank_mask:0xf
    v_bitop3_b32 v174, v130, s84, v174 bitop3:0xbe
    v_mfma_f32_16x16x32_bf16 v[222:225], v[126:129], v[40:43], 0
    v_max_f32_dpp v6, v6, v6 row_ror:4 row_mask:0xf bank_mask:0xf
    v_bitop3_b32 v174, v133, s84, v174 bitop3:0xbe
    v_bitop3_b32 v174, v138, s84, v174 bitop3:0xbe
    v_mfma_f32_16x16x32_bf16 v[226:229], v[126:129], v[44:47], 0
    v_max_f32_dpp v6, v6, v6 row_ror:8 row_mask:0xf bank_mask:0xf
    v_bitop3_b32 v174, v114, s84, v174 bitop3:0xbe
    v_cmp_ne_u32 vcc, 0, v174
    s_cbranch_vccnz L_retry2
L_ok2:
    s_waitcnt lgkmcnt(0)
    v_mfma_f32_16x16x32_bf16 v[214:217], v[134:137], v[48:51], v[214:217]
    v_sub_f32 v7, v112, v6
    v_exp_f32 v7, v7
    v_mfma_f32_16x16x32_bf16 v[218:221], v[134:137], v[52:55], v[218:221]
    v_mul_f32 v6, v7, v113
    s_nop 1
    v_add_f32_dpp v6, v6, v6 row_ror:1 row_mask:0xf bank_mask:0xf
    v_mfma_f32_16x16x32_bf16 v[222:225], v[134:137], v[56:59], v[222:225]
    s_nop 0
    v_add_f32_dpp v6, v6, v6 row_ror:2 row_mask:0xf bank_mask:0xf
    s_nop 1
    v_add_f32_dpp v6, v6, v6 row_ror:4 row_mask:0xf bank_mask:0xf
    v_mfma_f32_16x16x32_bf16 v[226:229], v[134:137], v[60:63], v[226:229]
    s_nop 0
    v_add_f32_dpp v6, v6, v6 row_ror:8 row_mask:0xf bank_mask:0xf
    v_rcp_f32 v6, v6
    s_nop 0
    v_mul_f32 v7, v7, v6
    s_nop 1
    v_fmac_f32_dpp v190, v7, v214 row_newbcast:0 row_mask:0xf bank_mask:0xf
    v_fmac_f32_dpp v194, v7, v218 row_newbcast:0 row_mask:0xf bank_mask:0xf
    v_fmac_f32_dpp v198, v7, v222 row_newbcast:0 row_mask:0xf bank_mask:0xf
    v_fmac_f32_dpp v202, v7, v226 row_newbcast:0 row_mask:0xf bank_mask:0xf
    v_fmac_f32_dpp v190, v7, v215 row_newbcast:1 row_mask:0xf bank_mask:0xf
    v_fmac_f32_dpp v194, v7, v219 row_newbcast:1 row_mask:0xf bank_mask:0xf
    v_fmac_f32_dpp v198, v7, v223 row_newbcast:1 row_mask:0xf bank_mask:0xf
    v_fmac_f32_dpp v202, v7, v227 row_newbcast:1 row_mask:0xf bank_mask:0xf
    v_fmac_f32_dpp v190, v7, v216 row_newbcast:2 row_mask:0xf bank_mask:0xf
    v_fmac_f32_dpp v194, v7, v220 row_newbcast:2 row_mask:0xf bank_mask:0xf
    v_fmac_f32_dpp v198, v7, v224 row_newbcast:2 row_mask:0xf bank_mask:0xf
    v_fmac_f32_dpp v202, v7, v228 row_newbcast:2 row_mask:0xf bank_mask:0xf
    v_fmac_f32_dpp v190, v7, v217 row_newbcast:3 row_mask:0xf bank_mask:0xf
    v_fmac_f32_dpp v194, v7, v221 row_newbcast:3 row_mask:0xf bank_mask:0xf
    v_fmac_f32_dpp v198, v7, v225 row_newbcast:3 row_mask:0xf bank_mask:0xf
    v_fmac_f32_dpp v202, v7, v229 row_newbcast:3 row_mask:0xf bank_mask:0xf
    s_nop 0
    v_permlane32_swap_b32 v190, v198
    v_permlane32_swap_b32 v194, v202
    v_add_f32 v190, v190, v198
    v_add_f32 v194, v194, v202
    s_cmp_eq_u32 s46, 0
    s_nop 0
    v_permlane16_swap_b32 v190, v194
    v_add_f32 v156, v190, v194
    buffer_store_dwordx2 v[156:157], v99, s[40:43], s78 offen sc1
    s_waitcnt vmcnt(0)
    s_barrier
    s_cbranch_scc0 L_fin
    s_mov_b32 s91, 0
    s_waitcnt vmcnt(0)
L_poll3:
    buffer_load_dwordx4 v[32:35], v100, s[40:43], s79 offen sc1
    buffer_load_dwordx4 v[36:39], v100, s[40:43], s80 offen sc1
    s_add_u32 s91, s91, 1
    s_cmp_gt_u32 s91, 200000
    s_cbranch_scc1 L_ok3
    s_waitcnt vmcnt(0)
    s_mov_b64 exec, -1
    v_add_f32 v214, v32, v36
    v_add_f32 v215, v34, v38
    v_xor_b32 v6, s84, v33
    v_add_f32_dpp v214, v214, v214 row_ror:2 row_mask:0xf bank_mask:0xf
    v_add_f32_dpp v215, v215, v215 row_ror:2 row_mask:0xf bank_mask:0xf
    v_bitop3_b32 v6, v35, s84, v6 bitop3:0xbe
    v_add_f32_dpp v214, v214, v214 row_ror:4 row_mask:0xf bank_mask:0xf
    v_add_f32_dpp v215, v215, v215 row_ror:4 row_mask:0xf bank_mask:0xf
    v_bitop3_b32 v6, v37, s84, v6 bitop3:0xbe
    v_add_f32_dpp v214, v214, v214 row_ror:8 row_mask:0xf bank_mask:0xf
    v_add_f32_dpp v215, v215, v215 row_ror:8 row_mask:0xf bank_mask:0xf
    v_bitop3_b32 v6, v39, s84, v6 bitop3:0xbe
    v_cmp_ne_u32 vcc, 0, v6
    v_permlane16_swap_b32 v214, v215
    v_add_f32 v214, v214, v215
    v_mov_b32 v215, v214
    s_cbranch_vccnz L_retry3
L_ok3:
    s_cmp_eq_u32 s2, 0
    v_permlane32_swap_b32 v214, v215
    v_add_f32 v214, v214, v215
    v_add_f32 v214, v214, v102
    v_cvt_pk_bf16_f32 v214, v214, v214
    s_mov_b32 exec_lo, 0x00030003
    s_mov_b32 exec_hi, 0
    buffer_store_short v214, v86, s[36:39], s56 offen nt
    s_cbranch_scc0 L_fin
    s_mov_b32 exec_lo, 1
    v_mov_b32 v6, 0
    buffer_store_dword v157, v6, s[40:43], 0 offen nt
L_fin:
L_end:
    s_endpgm
L_retry3:
    s_mov_b64 exec, vcc
    s_branch L_poll3
L_retry1:
    s_add_u32 s91, s91, 1
    s_cmp_gt_u32 s91, 200000
    s_cbranch_scc1 L_ok1
    s_cmp_lt_u32 s91, 12
    s_cbranch_scc1 L_r1b
    s_cmp_eq_u32 s91, 12
    s_cbranch_scc0 L_r1a
    v_mov_b32 v6, 1
    ds_write_b32 v83, v6 offset:5760
    ds_read_b128 v[112:115], v8 offset:5888
    v_and_b32 v6, 1, v0
    v_lshlrev_b32 v6, 13, v6
    v_lshrrev_b32 v7, 1, v0
    v_lshl_add_u32 v6, v7, 4, v6
    s_and_b32 s53, s68, 0xffffff00
    s_add_u32 s53, s53, 131072
    s_waitcnt lgkmcnt(0)
    v_xor_b32 v112, s88, v112
    s_mov_b32 exec_lo, -1
    s_mov_b32 exec_hi, 0
    buffer_store_dwordx4 v[112:115], v6, s[40:43], s53 offen sc1
    s_mov_b64 exec, -1
L_r1a:
    s_xor_b32 s89, s89, s88
    s_xor_b32 s70, s70, 131072
    s_nop 1
L_r1b:
    buffer_load_dwordx4 v[112:115], v90, s[40:43], s70 offen sc1
    buffer_load_dwordx4 v[116:119], v90, s[40:43], s70 offen offset:2048 sc1
    s_waitcnt vmcnt(0)
    s_branch L_chk1
L_mixed:
    s_add_u32 s69, s69, 131072
    s_mov_b32 exec_lo, 0x01010101
    s_mov_b32 exec_hi, 0x01010101
    v_xor_b32 v170, s88, v170
    buffer_store_dwordx4 v[170:173], v89, s[40:43], s69 offen sc1
    s_waitcnt vmcnt(0)
    s_mov_b64 exec, -1
    s_branch L_mixback
L_retryh:
    s_add_u32 s91, s91, 1
    s_cmp_gt_u32 s91, 200000
    s_cbranch_scc1 L_okh
    s_cmp_eq_u32 s92, 0
    s_cbranch_scc1 L_rhb
    s_xor_b32 s90, s90, s88
    s_xor_b32 s71, s71, 131072
L_rhb:
    buffer_load_dwordx4 v[120:123], v91, s[40:43], s71 offen sc1
    s_waitcnt vmcnt(0)
    s_branch L_chkh
L_mlmix:
    buffer_store_dwordx4 v[164:167], v6, s[40:43], s72 offen sc1
    s_branch L_mlback
L_psmix:
    buffer_store_dwordx4 v[156:159], v97, s[40:43], s73 offen sc1
    s_branch L_psback
L_retry2:
    s_add_u32 s91, s91, 1
    s_cmp_gt_u32 s91, 200000
    s_cbranch_scc1 L_giveup2
    s_mov_b64 exec, vcc
    buffer_load_dwordx4 v[124:127], v8, s[40:43], s76 offen offset:0 sc1
    buffer_load_dwordx4 v[128:131], v8, s[40:43], s76 offen offset:1024 sc1
    buffer_load_dwordx4 v[132:135], v8, s[40:43], s76 offen offset:2048 sc1
    buffer_load_dwordx4 v[136:139], v8, s[40:43], s76 offen offset:3072 sc1
    buffer_load_dwordx4 v[112:115], v98, s[40:43], s77 offen sc1
    s_waitcnt vmcnt(0)
    v_xor_b32 v174, s84, v125
    v_bitop3_b32 v174, v130, s84, v174 bitop3:0xbe
    v_bitop3_b32 v174, v133, s84, v174 bitop3:0xbe
    v_bitop3_b32 v174, v138, s84, v174 bitop3:0xbe
    v_bitop3_b32 v174, v114, s84, v174 bitop3:0xbe
    v_cmp_ne_u32 vcc, 0, v174
    s_cbranch_vccnz L_retry2
    s_mov_b64 exec, -1
    s_nop 3
    s_branch L_chk2
L_giveup2:
    s_mov_b64 exec, -1
    s_branch L_ok2
L_codeend:

.section .rodata,"a"
.p2align 6
.amdhsa_kernel parallel_sum__sliding_block_cached__dense_activation_mish__decode_kernel
  .amdhsa_next_free_vgpr 232
  .amdhsa_next_free_sgpr 102
  .amdhsa_accum_offset 232
  .amdhsa_group_segment_fixed_size 0
  .amdhsa_kernarg_size 96
  .amdhsa_user_sgpr_count 2
  .amdhsa_user_sgpr_kernarg_segment_ptr 1
  .amdhsa_system_sgpr_workgroup_id_x 1
.end_amdhsa_kernel
```
